```python
import torch

def _softmax(x, axis=-1):
    return torch.softmax(x, dim=axis)
def _gelu(x):
    return torch.nn.functional.gelu(x, approximate="tanh")
def _silu(x):
    return torch.nn.functional.silu(x)
def _sigmoid(x):
    return torch.sigmoid(x)
def _layernorm(x, axis=-1, eps=1e-5):
    m = x.mean(dim=axis, keepdim=True)
    v = x.var(dim=axis, keepdim=True, unbiased=False)
    return (x - m) / torch.sqrt(v + eps)
def _scatter_add(tgt, idx, src, axis=0):
    return tgt.clone().index_add_(axis, idx, src)
def _segment_sum(src, seg, n):
    out = torch.zeros((n,) + src.shape[1:], dtype=src.dtype)
    return out.index_add_(0, seg, src)
def _pad(x, pw):
    flat = tuple(v for pair in reversed(pw) for v in pair)
    return torch.nn.functional.pad(x, flat)

kernel_name = 'standalone__low_rank_proj_linformer__sampling'

def setup_inputs():

    _w = (lambda a: (lambda t: t.to(torch.bfloat16) if t.is_floating_point() else t)(torch.as_tensor(a)))
    B, H, Sq, Skv, Dh, R = 8, 32, 4, 2048, 128, 16
    return {
        "q": _w((lambda *s: torch.randn(*s, dtype=torch.bfloat16) * 0.8)(B, H, Sq, Dh)),
        "k": _w((lambda *s: torch.randn(*s, dtype=torch.bfloat16) * 0.8)(B, H, Skv, Dh)),
        "v": _w((lambda *s: torch.randn(*s, dtype=torch.bfloat16) * 0.05)(B, H, Skv, Dh)),
        "e_proj": _w((lambda *s: torch.randn(*s, dtype=torch.bfloat16) * 0.8)(R, Skv) * (Skv ** -0.5)),
        "f_proj": _w((lambda *s: torch.randn(*s, dtype=torch.bfloat16) * 0.05)(R, Skv) * (Skv ** -0.5)),
    }

def reference(q, k, v, e_proj, f_proj):
    B, H, Sq, Dh = q.shape
    kp = torch.einsum("rn,bhnd->bhrd", e_proj, k)
    vp = torch.einsum("rn,bhnd->bhrd", f_proj, v)
    scores = torch.einsum("bhqd,bhrd->bhqr", q, kp) * (Dh ** -0.5)
    p = _softmax(scores, axis=-1)
    o = torch.einsum("bhqr,bhrd->bhqd", p, vp)
    return o
```

```asm
; @launch grid=(256,1,1) block=(64,1,1) lds=83968
.amdgcn_target "amdgcn-amd-amdhsa--gfx950"
.text
.globl standalone__low_rank_proj_linformer__sampling_kernel
.p2align 8
.type standalone__low_rank_proj_linformer__sampling_kernel,@function
standalone__low_rank_proj_linformer__sampling_kernel:
    s_load_dwordx2 s[4:5], s[0:1], 8
    s_load_dwordx2 s[12:13], s[0:1], 24
    s_cmp_ge_u32 s2, 256
    s_cbranch_scc1 L_end
    s_and_b32 s3, s2, 7
    s_lshl_b32 s3, s3, 5
    s_lshr_b32 s33, s2, 3
    s_or_b32 s3, s3, s33
    v_and_b32 v3, 15, v0
    v_lshrrev_b32 v1, 4, v0
    v_lshlrev_b32 v1, 11, v1
    v_lshl_or_b32 v1, v3, 4, v1
    s_lshl_b32 s31, s3, 19
    s_mul_i32 s33, s3, 1024
    s_and_b32 s33, s33, 0xfff
    s_lshl_b32 s28, s33, 7
    s_add_u32 s28, s28, s31
    s_mov_b32 s6, 0x8000000
    s_mov_b32 s7, 0x20000
    v_and_b32 v2, 0x30, v0
    v_lshl_or_b32 v2, v3, 12, v2
    s_mov_b32 s14, 0x10000
    s_mov_b32 s15, 0x20000
    s_waitcnt lgkmcnt(0)
    buffer_load_dwordx4 v[88:91], v1, s[4:7], s28 offen offset:0 nt
    buffer_load_dwordx4 a[0:3], v2, s[12:15], s33 offen
    buffer_load_dwordx4 v[92:95], v1, s[4:7], s28 offen offset:256 nt
    buffer_load_dwordx4 v[96:99], v1, s[4:7], s28 offen offset:512 nt
    buffer_load_dwordx4 v[100:103], v1, s[4:7], s28 offen offset:768 nt
    buffer_load_dwordx4 v[104:107], v1, s[4:7], s28 offen offset:1024 nt
    buffer_load_dwordx4 v[108:111], v1, s[4:7], s28 offen offset:1280 nt
    buffer_load_dwordx4 v[112:115], v1, s[4:7], s28 offen offset:1536 nt
    buffer_load_dwordx4 v[116:119], v1, s[4:7], s28 offen offset:1792 nt
    s_load_dwordx2 s[8:9], s[0:1], 16
    s_load_dwordx2 s[16:17], s[0:1], 32
    s_load_dwordx2 s[20:21], s[0:1], 0
    s_load_dwordx2 s[24:25], s[0:1], 40
    s_add_u32 s33, s33, 64
    s_and_b32 s33, s33, 0xfff
    s_lshl_b32 s28, s33, 7
    s_add_u32 s28, s28, s31
    buffer_load_dwordx4 v[120:123], v1, s[4:7], s28 offen offset:0 nt
    buffer_load_dwordx4 a[4:7], v2, s[12:15], s33 offen
    buffer_load_dwordx4 v[124:127], v1, s[4:7], s28 offen offset:256 nt
    buffer_load_dwordx4 v[128:131], v1, s[4:7], s28 offen offset:512 nt
    buffer_load_dwordx4 v[132:135], v1, s[4:7], s28 offen offset:768 nt
    buffer_load_dwordx4 v[136:139], v1, s[4:7], s28 offen offset:1024 nt
    buffer_load_dwordx4 v[140:143], v1, s[4:7], s28 offen offset:1280 nt
    buffer_load_dwordx4 v[144:147], v1, s[4:7], s28 offen offset:1536 nt
    buffer_load_dwordx4 v[148:151], v1, s[4:7], s28 offen offset:1792 nt
    s_add_u32 s33, s33, 64
    s_and_b32 s33, s33, 0xfff
    s_lshl_b32 s28, s33, 7
    s_add_u32 s28, s28, s31
    buffer_load_dwordx4 v[152:155], v1, s[4:7], s28 offen offset:0 nt
    buffer_load_dwordx4 a[8:11], v2, s[12:15], s33 offen
    s_mov_b32 s22, 0x40000
    s_mov_b32 s23, 0x20000
    s_lshl_b32 s32, s3, 10
    v_and_b32 v12, 0x30, v0
    v_mul_u32_u24 v9, 272, v3
    v_add_u32 v9, v9, v12
    v_lshrrev_b32 v3, 2, v3
    v_lshl_add_u32 v3, v3, 8, v12
    s_mov_b32 s10, 0x8000000
    s_mov_b32 s11, 0x20000
    s_mov_b32 s18, 0x10000
    s_mov_b32 s19, 0x20000
    s_mov_b32 s26, 0x40000
    s_mov_b32 s27, 0x20000
    s_waitcnt lgkmcnt(0)
    buffer_load_dwordx4 a[16:19], v3, s[20:23], s32 offen offset:0
    buffer_load_dwordx4 a[20:23], v3, s[20:23], s32 offen offset:64
    buffer_load_dwordx4 a[24:27], v3, s[20:23], s32 offen offset:128
    buffer_load_dwordx4 a[28:31], v3, s[20:23], s32 offen offset:192
    s_mov_b64 exec, 1
    buffer_load_dword v52, v1, s[8:11], s31 offen
    buffer_load_dword v53, v1, s[16:19], 0 offen
    s_mov_b64 exec, -1
    buffer_load_dwordx4 v[156:159], v1, s[4:7], s28 offen offset:256 nt
    buffer_load_dwordx4 v[160:163], v1, s[4:7], s28 offen offset:512 nt
    buffer_load_dwordx4 v[164:167], v1, s[4:7], s28 offen offset:768 nt
    buffer_load_dwordx4 v[168:171], v1, s[4:7], s28 offen offset:1024 nt
    buffer_load_dwordx4 v[172:175], v1, s[4:7], s28 offen offset:1280 nt
    buffer_load_dwordx4 v[176:179], v1, s[4:7], s28 offen offset:1536 nt
    buffer_load_dwordx4 v[180:183], v1, s[4:7], s28 offen offset:1792 nt
    s_add_u32 s33, s33, 64
    s_and_b32 s33, s33, 0xfff
    s_lshl_b32 s28, s33, 7
    s_add_u32 s28, s28, s31
    buffer_load_dwordx4 v[184:187], v1, s[4:7], s28 offen offset:0 nt
    buffer_load_dwordx4 a[12:15], v2, s[12:15], s33 offen
    buffer_load_dwordx4 v[188:191], v1, s[4:7], s28 offen offset:256 nt
    buffer_load_dwordx4 v[192:195], v1, s[4:7], s28 offen offset:512 nt
    buffer_load_dwordx4 v[196:199], v1, s[4:7], s28 offen offset:768 nt
    s_mov_b32 s29, 0x05040100
    s_mov_b32 s30, 0x07060302
    v_lshlrev_b32 v4, 4, v0
    v_and_b32 v12, 0x30, v0
    v_mul_u32_u24 v8, 68, v12
    v_and_b32 v12, 0xf0, v4
    v_add_u32 v8, v8, v12
    v_mov_b64 v[20:21], 0
    v_mov_b64 v[22:23], 0
    v_mov_b64 v[24:25], 0
    v_mov_b64 v[26:27], 0
    v_mov_b64 v[28:29], 0
    v_mov_b64 v[30:31], 0
    v_mov_b64 v[32:33], 0
    v_mov_b64 v[34:35], 0
    v_mov_b64 v[36:37], 0
    v_mov_b64 v[38:39], 0
    v_mov_b64 v[40:41], 0
    v_mov_b64 v[42:43], 0
    v_mov_b64 v[44:45], 0
    v_mov_b64 v[46:47], 0
    v_mov_b64 v[48:49], 0
    v_mov_b64 v[50:51], 0
    s_mov_b32 s34, 32
.p2align 3
L_loop:
    s_waitcnt vmcnt(20)
    buffer_load_dwordx4 v[200:203], v1, s[4:7], s28 offen offset:1024 nt
    buffer_load_dwordx4 v[204:207], v1, s[4:7], s28 offen offset:1280 nt
    buffer_load_dwordx4 v[208:211], v1, s[4:7], s28 offen offset:1536 nt
    buffer_load_dwordx4 v[212:215], v1, s[4:7], s28 offen offset:1792 nt
    v_perm_b32 v12, v92, v88, s29
    v_perm_b32 v13, v100, v96, s29
    v_perm_b32 v14, v108, v104, s29
    v_perm_b32 v15, v116, v112, s29
    v_perm_b32 v16, v92, v88, s30
    v_perm_b32 v17, v100, v96, s30
    v_perm_b32 v18, v108, v104, s30
    v_perm_b32 v19, v116, v112, s30
    v_mfma_f32_16x16x32_bf16 v[20:23], a[0:3], v[12:15], v[20:23]
    v_perm_b32 v12, v93, v89, s29
    v_perm_b32 v13, v101, v97, s29
    v_perm_b32 v14, v109, v105, s29
    v_perm_b32 v15, v117, v113, s29
    v_mfma_f32_16x16x32_bf16 v[24:27], a[0:3], v[16:19], v[24:27]
    v_perm_b32 v16, v93, v89, s30
    v_perm_b32 v17, v101, v97, s30
    v_perm_b32 v18, v109, v105, s30
    v_perm_b32 v19, v117, v113, s30
    v_mfma_f32_16x16x32_bf16 v[28:31], a[0:3], v[12:15], v[28:31]
    v_perm_b32 v12, v94, v90, s29
    v_perm_b32 v13, v102, v98, s29
    v_perm_b32 v14, v110, v106, s29
    v_perm_b32 v15, v118, v114, s29
    v_mfma_f32_16x16x32_bf16 v[32:35], a[0:3], v[16:19], v[32:35]
    v_perm_b32 v16, v94, v90, s30
    v_perm_b32 v17, v102, v98, s30
    v_perm_b32 v18, v110, v106, s30
    v_perm_b32 v19, v118, v114, s30
    v_mfma_f32_16x16x32_bf16 v[36:39], a[0:3], v[12:15], v[36:39]
    v_perm_b32 v12, v95, v91, s29
    v_perm_b32 v13, v103, v99, s29
    v_perm_b32 v14, v111, v107, s29
    v_perm_b32 v15, v119, v115, s29
    v_mfma_f32_16x16x32_bf16 v[40:43], a[0:3], v[16:19], v[40:43]
    v_perm_b32 v16, v95, v91, s30
    v_perm_b32 v17, v103, v99, s30
    v_perm_b32 v18, v111, v107, s30
    v_perm_b32 v19, v119, v115, s30
    v_mfma_f32_16x16x32_bf16 v[44:47], a[0:3], v[12:15], v[44:47]
    s_nop 1
    v_mfma_f32_16x16x32_bf16 v[48:51], a[0:3], v[16:19], v[48:51]
    s_cmp_gt_u32 s34, 17
    s_cselect_b64 s[4:5], s[4:5], s[8:9]
    s_cselect_b64 s[12:13], s[12:13], s[16:17]
    s_cmp_gt_u32 s34, 1
    s_cselect_b32 s6, s6, 0
    s_cselect_b32 s14, s14, 0
    s_add_u32 s33, s33, 64
    s_and_b32 s33, s33, 0xfff
    s_lshl_b32 s28, s33, 7
    s_add_u32 s28, s28, s31
    buffer_load_dwordx4 v[88:91], v1, s[4:7], s28 offen offset:0 nt
    buffer_load_dwordx4 a[0:3], v2, s[12:15], s33 offen
    buffer_load_dwordx4 v[92:95], v1, s[4:7], s28 offen offset:256 nt
    buffer_load_dwordx4 v[96:99], v1, s[4:7], s28 offen offset:512 nt
    buffer_load_dwordx4 v[100:103], v1, s[4:7], s28 offen offset:768 nt
    s_cmp_eq_u32 s34, 16
    s_cbranch_scc1 L_piece2
L_back2:
    s_waitcnt vmcnt(20)
    buffer_load_dwordx4 v[104:107], v1, s[4:7], s28 offen offset:1024 nt
    buffer_load_dwordx4 v[108:111], v1, s[4:7], s28 offen offset:1280 nt
    buffer_load_dwordx4 v[112:115], v1, s[4:7], s28 offen offset:1536 nt
    buffer_load_dwordx4 v[116:119], v1, s[4:7], s28 offen offset:1792 nt
    v_perm_b32 v12, v124, v120, s29
    v_perm_b32 v13, v132, v128, s29
    v_perm_b32 v14, v140, v136, s29
    v_perm_b32 v15, v148, v144, s29
    v_perm_b32 v16, v124, v120, s30
    v_perm_b32 v17, v132, v128, s30
    v_perm_b32 v18, v140, v136, s30
    v_perm_b32 v19, v148, v144, s30
    v_mfma_f32_16x16x32_bf16 v[20:23], a[4:7], v[12:15], v[20:23]
    v_perm_b32 v12, v125, v121, s29
    v_perm_b32 v13, v133, v129, s29
    v_perm_b32 v14, v141, v137, s29
    v_perm_b32 v15, v149, v145, s29
    v_mfma_f32_16x16x32_bf16 v[24:27], a[4:7], v[16:19], v[24:27]
    v_perm_b32 v16, v125, v121, s30
    v_perm_b32 v17, v133, v129, s30
    v_perm_b32 v18, v141, v137, s30
    v_perm_b32 v19, v149, v145, s30
    v_mfma_f32_16x16x32_bf16 v[28:31], a[4:7], v[12:15], v[28:31]
    v_perm_b32 v12, v126, v122, s29
    v_perm_b32 v13, v134, v130, s29
    v_perm_b32 v14, v142, v138, s29
    v_perm_b32 v15, v150, v146, s29
    v_mfma_f32_16x16x32_bf16 v[32:35], a[4:7], v[16:19], v[32:35]
    v_perm_b32 v16, v126, v122, s30
    v_perm_b32 v17, v134, v130, s30
    v_perm_b32 v18, v142, v138, s30
    v_perm_b32 v19, v150, v146, s30
    v_mfma_f32_16x16x32_bf16 v[36:39], a[4:7], v[12:15], v[36:39]
    v_perm_b32 v12, v127, v123, s29
    v_perm_b32 v13, v135, v131, s29
    v_perm_b32 v14, v143, v139, s29
    v_perm_b32 v15, v151, v147, s29
    v_mfma_f32_16x16x32_bf16 v[40:43], a[4:7], v[16:19], v[40:43]
    v_perm_b32 v16, v127, v123, s30
    v_perm_b32 v17, v135, v131, s30
    v_perm_b32 v18, v143, v139, s30
    v_perm_b32 v19, v151, v147, s30
    v_mfma_f32_16x16x32_bf16 v[44:47], a[4:7], v[12:15], v[44:47]
    s_nop 1
    v_mfma_f32_16x16x32_bf16 v[48:51], a[4:7], v[16:19], v[48:51]
    s_add_u32 s33, s33, 64
    s_and_b32 s33, s33, 0xfff
    s_lshl_b32 s28, s33, 7
    s_add_u32 s28, s28, s31
    buffer_load_dwordx4 v[120:123], v1, s[4:7], s28 offen offset:0 nt
    buffer_load_dwordx4 a[4:7], v2, s[12:15], s33 offen
    buffer_load_dwordx4 v[124:127], v1, s[4:7], s28 offen offset:256 nt
    buffer_load_dwordx4 v[128:131], v1, s[4:7], s28 offen offset:512 nt
    buffer_load_dwordx4 v[132:135], v1, s[4:7], s28 offen offset:768 nt
    s_cmp_eq_u32 s34, 16
    s_cbranch_scc1 L_piece3
L_back3:
    s_waitcnt vmcnt(20)
    buffer_load_dwordx4 v[136:139], v1, s[4:7], s28 offen offset:1024 nt
    buffer_load_dwordx4 v[140:143], v1, s[4:7], s28 offen offset:1280 nt
    buffer_load_dwordx4 v[144:147], v1, s[4:7], s28 offen offset:1536 nt
    buffer_load_dwordx4 v[148:151], v1, s[4:7], s28 offen offset:1792 nt
    v_perm_b32 v12, v156, v152, s29
    v_perm_b32 v13, v164, v160, s29
    v_perm_b32 v14, v172, v168, s29
    v_perm_b32 v15, v180, v176, s29
    v_perm_b32 v16, v156, v152, s30
    v_perm_b32 v17, v164, v160, s30
    v_perm_b32 v18, v172, v168, s30
    v_perm_b32 v19, v180, v176, s30
    v_mfma_f32_16x16x32_bf16 v[20:23], a[8:11], v[12:15], v[20:23]
    v_perm_b32 v12, v157, v153, s29
    v_perm_b32 v13, v165, v161, s29
    v_perm_b32 v14, v173, v169, s29
    v_perm_b32 v15, v181, v177, s29
    v_mfma_f32_16x16x32_bf16 v[24:27], a[8:11], v[16:19], v[24:27]
    v_perm_b32 v16, v157, v153, s30
    v_perm_b32 v17, v165, v161, s30
    v_perm_b32 v18, v173, v169, s30
    v_perm_b32 v19, v181, v177, s30
    v_mfma_f32_16x16x32_bf16 v[28:31], a[8:11], v[12:15], v[28:31]
    v_perm_b32 v12, v158, v154, s29
    v_perm_b32 v13, v166, v162, s29
    v_perm_b32 v14, v174, v170, s29
    v_perm_b32 v15, v182, v178, s29
    v_mfma_f32_16x16x32_bf16 v[32:35], a[8:11], v[16:19], v[32:35]
    v_perm_b32 v16, v158, v154, s30
    v_perm_b32 v17, v166, v162, s30
    v_perm_b32 v18, v174, v170, s30
    v_perm_b32 v19, v182, v178, s30
    v_mfma_f32_16x16x32_bf16 v[36:39], a[8:11], v[12:15], v[36:39]
    v_perm_b32 v12, v159, v155, s29
    v_perm_b32 v13, v167, v163, s29
    v_perm_b32 v14, v175, v171, s29
    v_perm_b32 v15, v183, v179, s29
    v_mfma_f32_16x16x32_bf16 v[40:43], a[8:11], v[16:19], v[40:43]
    v_perm_b32 v16, v159, v155, s30
    v_perm_b32 v17, v167, v163, s30
    v_perm_b32 v18, v175, v171, s30
    v_perm_b32 v19, v183, v179, s30
    v_mfma_f32_16x16x32_bf16 v[44:47], a[8:11], v[12:15], v[44:47]
    s_nop 1
    v_mfma_f32_16x16x32_bf16 v[48:51], a[8:11], v[16:19], v[48:51]
    s_add_u32 s33, s33, 64
    s_and_b32 s33, s33, 0xfff
    s_lshl_b32 s28, s33, 7
    s_add_u32 s28, s28, s31
    buffer_load_dwordx4 v[152:155], v1, s[4:7], s28 offen offset:0 nt
    buffer_load_dwordx4 a[8:11], v2, s[12:15], s33 offen
    buffer_load_dwordx4 v[156:159], v1, s[4:7], s28 offen offset:256 nt
    buffer_load_dwordx4 v[160:163], v1, s[4:7], s28 offen offset:512 nt
    buffer_load_dwordx4 v[164:167], v1, s[4:7], s28 offen offset:768 nt
    s_cmp_eq_u32 s34, 16
    s_cbranch_scc1 L_piece4
L_back4:
    s_waitcnt vmcnt(20)
    buffer_load_dwordx4 v[168:171], v1, s[4:7], s28 offen offset:1024 nt
    buffer_load_dwordx4 v[172:175], v1, s[4:7], s28 offen offset:1280 nt
    buffer_load_dwordx4 v[176:179], v1, s[4:7], s28 offen offset:1536 nt
    buffer_load_dwordx4 v[180:183], v1, s[4:7], s28 offen offset:1792 nt
    v_perm_b32 v12, v188, v184, s29
    v_perm_b32 v13, v196, v192, s29
    v_perm_b32 v14, v204, v200, s29
    v_perm_b32 v15, v212, v208, s29
    v_perm_b32 v16, v188, v184, s30
    v_perm_b32 v17, v196, v192, s30
    v_perm_b32 v18, v204, v200, s30
    v_perm_b32 v19, v212, v208, s30
    v_mfma_f32_16x16x32_bf16 v[20:23], a[12:15], v[12:15], v[20:23]
    v_perm_b32 v12, v189, v185, s29
    v_perm_b32 v13, v197, v193, s29
    v_perm_b32 v14, v205, v201, s29
    v_perm_b32 v15, v213, v209, s29
    v_mfma_f32_16x16x32_bf16 v[24:27], a[12:15], v[16:19], v[24:27]
    v_perm_b32 v16, v189, v185, s30
    v_perm_b32 v17, v197, v193, s30
    v_perm_b32 v18, v205, v201, s30
    v_perm_b32 v19, v213, v209, s30
    v_mfma_f32_16x16x32_bf16 v[28:31], a[12:15], v[12:15], v[28:31]
    v_perm_b32 v12, v190, v186, s29
    v_perm_b32 v13, v198, v194, s29
    v_perm_b32 v14, v206, v202, s29
    v_perm_b32 v15, v214, v210, s29
    v_mfma_f32_16x16x32_bf16 v[32:35], a[12:15], v[16:19], v[32:35]
    v_perm_b32 v16, v190, v186, s30
    v_perm_b32 v17, v198, v194, s30
    v_perm_b32 v18, v206, v202, s30
    v_perm_b32 v19, v214, v210, s30
    v_mfma_f32_16x16x32_bf16 v[36:39], a[12:15], v[12:15], v[36:39]
    v_perm_b32 v12, v191, v187, s29
    v_perm_b32 v13, v199, v195, s29
    v_perm_b32 v14, v207, v203, s29
    v_perm_b32 v15, v215, v211, s29
    v_mfma_f32_16x16x32_bf16 v[40:43], a[12:15], v[16:19], v[40:43]
    v_perm_b32 v16, v191, v187, s30
    v_perm_b32 v17, v199, v195, s30
    v_perm_b32 v18, v207, v203, s30
    v_perm_b32 v19, v215, v211, s30
    v_mfma_f32_16x16x32_bf16 v[44:47], a[12:15], v[12:15], v[44:47]
    s_nop 1
    v_mfma_f32_16x16x32_bf16 v[48:51], a[12:15], v[16:19], v[48:51]
    s_cmp_eq_u32 s34, 1
    s_cbranch_scc1 L_tail
    s_add_u32 s33, s33, 64
    s_and_b32 s33, s33, 0xfff
    s_lshl_b32 s28, s33, 7
    s_add_u32 s28, s28, s31
    buffer_load_dwordx4 v[184:187], v1, s[4:7], s28 offen offset:0 nt
    buffer_load_dwordx4 a[12:15], v2, s[12:15], s33 offen
    buffer_load_dwordx4 v[188:191], v1, s[4:7], s28 offen offset:256 nt
    buffer_load_dwordx4 v[192:195], v1, s[4:7], s28 offen offset:512 nt
    buffer_load_dwordx4 v[196:199], v1, s[4:7], s28 offen offset:768 nt
    s_sub_u32 s34, s34, 1
    s_cmp_lg_u32 s34, 16
    s_cbranch_scc1 L_loop
L_piece1:
    v_cvt_pk_bf16_f32 v56, v20, v24
    v_cvt_pk_bf16_f32 v57, v28, v32
    v_cvt_pk_bf16_f32 v58, v36, v40
    v_cvt_pk_bf16_f32 v59, v44, v48
    v_cvt_pk_bf16_f32 v60, v21, v25
    v_cvt_pk_bf16_f32 v61, v29, v33
    v_cvt_pk_bf16_f32 v62, v37, v41
    v_cvt_pk_bf16_f32 v63, v45, v49
    v_cvt_pk_bf16_f32 v64, v22, v26
    v_cvt_pk_bf16_f32 v65, v30, v34
    v_cvt_pk_bf16_f32 v66, v38, v42
    v_cvt_pk_bf16_f32 v67, v46, v50
    v_cvt_pk_bf16_f32 v68, v23, v27
    v_cvt_pk_bf16_f32 v69, v31, v35
    v_cvt_pk_bf16_f32 v70, v39, v43
    v_cvt_pk_bf16_f32 v71, v47, v51
    ds_write_b128 v8, v[56:59] offset:0
    ds_write_b128 v8, v[60:63] offset:272
    ds_write_b128 v8, v[64:67] offset:544
    ds_write_b128 v8, v[68:71] offset:816
    ds_read_b128 v[72:75], v9 offset:0
    ds_read_b128 v[76:79], v9 offset:64
    ds_read_b128 v[80:83], v9 offset:128
    ds_read_b128 v[84:87], v9 offset:192
    v_mov_b64 v[20:21], 0
    v_mov_b64 v[22:23], 0
    v_mov_b64 v[24:25], 0
    v_mov_b64 v[26:27], 0
    v_mov_b64 v[28:29], 0
    v_mov_b64 v[30:31], 0
    v_mov_b64 v[32:33], 0
    v_mov_b64 v[34:35], 0
    v_mov_b64 v[36:37], 0
    v_mov_b64 v[38:39], 0
    v_mov_b64 v[40:41], 0
    v_mov_b64 v[42:43], 0
    v_mov_b64 v[44:45], 0
    v_mov_b64 v[46:47], 0
    v_mov_b64 v[48:49], 0
    v_mov_b64 v[50:51], 0
    s_branch L_loop
L_piece2:
    s_waitcnt lgkmcnt(0)
    v_mfma_f32_16x16x32_bf16 v[52:55], v[72:75], a[16:19], 0
    v_mfma_f32_16x16x32_bf16 v[52:55], v[76:79], a[20:23], v[52:55]
    v_mfma_f32_16x16x32_bf16 v[52:55], v[80:83], a[24:27], v[52:55]
    v_mfma_f32_16x16x32_bf16 v[52:55], v[84:87], a[28:31], v[52:55]
    s_branch L_back2
L_piece3:
    v_cvt_pk_bf16_f32 v56, v52, v53
    v_cvt_pk_bf16_f32 v57, v54, v55
    v_lshlrev_b32 v52, 16, v56
    v_and_b32 v53, 0xffff0000, v56
    v_lshlrev_b32 v54, 16, v57
    v_and_b32 v55, 0xffff0000, v57
    v_mul_f32 v52, 0x3db504f3, v52
    v_mul_f32 v53, 0x3db504f3, v53
    v_mul_f32 v54, 0x3db504f3, v54
    v_mul_f32 v55, 0x3db504f3, v55
    v_cvt_pk_bf16_f32 v56, v52, v53
    v_cvt_pk_bf16_f32 v57, v54, v55
    v_lshlrev_b32 v52, 16, v56
    v_and_b32 v53, 0xffff0000, v56
    v_lshlrev_b32 v54, 16, v57
    v_and_b32 v55, 0xffff0000, v57
    v_max_f32 v58, v52, v53
    v_max3_f32 v58, v54, v55, v58
    v_mov_b32 v59, v58
    s_nop 1
    v_permlane32_swap_b32 v58, v59
    s_nop 1
    v_max_f32 v58, v58, v59
    v_mov_b32 v59, v58
    s_nop 1
    v_permlane16_swap_b32 v58, v59
    s_nop 1
    v_max_f32 v58, v58, v59
    s_branch L_back3
L_piece4:
    v_sub_f32 v52, v52, v58
    v_sub_f32 v53, v53, v58
    v_sub_f32 v54, v54, v58
    v_sub_f32 v55, v55, v58
    v_mul_f32 v52, 0x3fb8aa3b, v52
    v_mul_f32 v53, 0x3fb8aa3b, v53
    v_mul_f32 v54, 0x3fb8aa3b, v54
    v_mul_f32 v55, 0x3fb8aa3b, v55
    v_exp_f32 v52, v52
    v_exp_f32 v53, v53
    v_exp_f32 v54, v54
    v_exp_f32 v55, v55
    s_nop 0
    v_add_f32 v58, v52, v53
    v_add_f32 v59, v54, v55
    v_add_f32 v58, v58, v59
    v_mov_b32 v59, v58
    s_nop 1
    v_permlane32_swap_b32 v58, v59
    s_nop 1
    v_add_f32 v58, v58, v59
    v_mov_b32 v59, v58
    s_nop 1
    v_permlane16_swap_b32 v58, v59
    s_nop 1
    v_add_f32 v58, v58, v59
    v_rcp_f32 v58, v58
    s_nop 0
    v_mul_f32 v52, v52, v58
    v_mul_f32 v53, v53, v58
    v_mul_f32 v54, v54, v58
    v_mul_f32 v55, v55, v58
    v_cvt_pk_bf16_f32 v6, v52, v53
    v_cvt_pk_bf16_f32 v7, v54, v55
    s_branch L_back4
L_tail:
    v_cvt_pk_bf16_f32 v52, v20, v21
    v_cvt_pk_bf16_f32 v53, v22, v23
    v_cvt_pk_bf16_f32 v54, v24, v25
    v_cvt_pk_bf16_f32 v55, v26, v27
    v_mfma_f32_16x16x16_bf16 v[20:23], v[6:7], v[52:53], 0
    v_cvt_pk_bf16_f32 v56, v28, v29
    v_cvt_pk_bf16_f32 v57, v30, v31
    v_mfma_f32_16x16x16_bf16 v[24:27], v[6:7], v[54:55], 0
    v_cvt_pk_bf16_f32 v58, v32, v33
    v_cvt_pk_bf16_f32 v59, v34, v35
    v_mfma_f32_16x16x16_bf16 v[28:31], v[6:7], v[56:57], 0
    v_cvt_pk_bf16_f32 v60, v36, v37
    v_cvt_pk_bf16_f32 v61, v38, v39
    v_mfma_f32_16x16x16_bf16 v[32:35], v[6:7], v[58:59], 0
    v_cvt_pk_bf16_f32 v62, v40, v41
    v_cvt_pk_bf16_f32 v63, v42, v43
    v_mfma_f32_16x16x16_bf16 v[36:39], v[6:7], v[60:61], 0
    v_cvt_pk_bf16_f32 v64, v44, v45
    v_cvt_pk_bf16_f32 v65, v46, v47
    v_mfma_f32_16x16x16_bf16 v[40:43], v[6:7], v[62:63], 0
    v_cvt_pk_bf16_f32 v66, v48, v49
    v_cvt_pk_bf16_f32 v67, v50, v51
    v_mfma_f32_16x16x16_bf16 v[44:47], v[6:7], v[64:65], 0
    s_nop 1
    v_mfma_f32_16x16x16_bf16 v[48:51], v[6:7], v[66:67], 0
    s_nop 4
    v_cvt_pk_bf16_f32 v12, v20, v24
    v_cvt_pk_bf16_f32 v13, v28, v32
    v_cvt_pk_bf16_f32 v14, v36, v40
    v_cvt_pk_bf16_f32 v15, v44, v48
    buffer_store_dwordx4 v[12:15], v4, s[24:27], s32 offen
L_end:
    s_endpgm
.section .rodata,"a"
.p2align 6
.amdhsa_kernel standalone__low_rank_proj_linformer__sampling_kernel
  .amdhsa_next_free_vgpr 248
  .amdhsa_next_free_sgpr 48
  .amdhsa_accum_offset 216
  .amdhsa_group_segment_fixed_size 0
  .amdhsa_kernarg_size 64
  .amdhsa_user_sgpr_count 2
  .amdhsa_user_sgpr_kernarg_segment_ptr 1
  .amdhsa_system_sgpr_workgroup_id_x 1
  .amdhsa_float_denorm_mode_32 3
.end_amdhsa_kernel
```
